```python
import torch

def _softmax(x, axis=-1):
    return torch.softmax(x, dim=axis)
def _gelu(x):
    return torch.nn.functional.gelu(x, approximate="tanh")
def _silu(x):
    return torch.nn.functional.silu(x)
def _sigmoid(x):
    return torch.sigmoid(x)
def _layernorm(x, axis=-1, eps=1e-5):
    m = x.mean(dim=axis, keepdim=True)
    v = x.var(dim=axis, keepdim=True, unbiased=False)
    return (x - m) / torch.sqrt(v + eps)
def _scatter_add(tgt, idx, src, axis=0):
    return tgt.clone().index_add_(axis, idx, src)
def _segment_sum(src, seg, n):
    out = torch.zeros((n,) + src.shape[1:], dtype=src.dtype)
    return out.index_add_(0, seg, src)
def _pad(x, pw):
    flat = tuple(v for pair in reversed(pw) for v in pair)
    return torch.nn.functional.pad(x, flat)

kernel_name = 'parallel_sum__sliding_block_cached__glu_gated_glu__decode'

def setup_inputs():

    _w = (lambda a: (lambda t: t.to(torch.bfloat16) if t.is_floating_point() else t)(torch.as_tensor(a)))
    def _A_setup():
        B, Sq, D = 2, 1, 512
        Hq, Hkv, Sk, Dh = 32, 8, 32768, 128
        assert Hq % Hkv == 0, (Hq, Hkv)
        return {
            "x": _w((lambda *s: torch.randn(*s, dtype=torch.bfloat16) * 0.05)(B, Sq, D)),
            "k_cache": _w((lambda *s: torch.randn(*s, dtype=torch.bfloat16) * 3.2)(B, Hkv, Sk, Dh)),
            "v_cache": _w((lambda *s: torch.randn(*s, dtype=torch.bfloat16) * 1.6)(B, Hkv, Sk, Dh)),
            "wq": _w((lambda *s: torch.randn(*s, dtype=torch.bfloat16) * 3.2)(D, Hq * Dh) * (D ** -0.5)),
            "wo": _w((lambda *s: torch.randn(*s, dtype=torch.bfloat16) * 1.6)(Hq * Dh, D) * ((Hq * Dh) ** -0.5)),
        }
    _A_in = _A_setup()

    def _B_setup():
        B, S, D, F = 2, 1, 512, 1792
        return {
            "x": _w((lambda *s: torch.randn(*s, dtype=torch.bfloat16) * 0.05)(B, S, D)),
            "w_gate": _w((lambda *s: torch.randn(*s, dtype=torch.bfloat16) * 1.6)(D, F)),
            "w_up": _w((lambda *s: torch.randn(*s, dtype=torch.bfloat16) * 0.05)(D, F)),
            "w_down": _w((lambda *s: torch.randn(*s, dtype=torch.bfloat16) * 0.05)(F, D)),
        }
    _B_in = _B_setup()

    return {
        "A_x": _A_in["x"],
        "A_k_cache": _A_in["k_cache"],
        "A_v_cache": _A_in["v_cache"],
        "A_wq": _A_in["wq"],
        "A_wo": _A_in["wo"],
        "B_x": _B_in["x"],
        "B_w_gate": _B_in["w_gate"],
        "B_w_up": _B_in["w_up"],
        "B_w_down": _B_in["w_down"],
    }

def reference(A_x, A_k_cache, A_v_cache, A_wq, A_wo, B_x, B_w_gate, B_w_up, B_w_down):
    def _A_ref(x, k_cache, v_cache, wq, wo):
        B, Sq, D = x.shape
        Hq, Dh = 32, 128
        Hkv, Sk = k_cache.shape[1], k_cache.shape[2]
        W = min(4096, max(256, Sk // 4))
        rep = Hq // Hkv
        q = (lambda x, *d: x.permute(*d))((x @ wq).reshape(B, Sq, Hq, Dh), 0, 2, 1, 3)
        k = (lambda x, n, axis: torch.repeat_interleave(x, n, dim=axis))(k_cache[:, :, Sk - W:, :], rep, axis=1)
        v = (lambda x, n, axis: torch.repeat_interleave(x, n, dim=axis))(v_cache[:, :, Sk - W:, :], rep, axis=1)
        scores = torch.einsum("bhqd,bhkd->bhqk", q, k) * (Dh ** -0.5)
        p = _softmax(scores, axis=-1)
        o = torch.einsum("bhqk,bhkd->bhqd", p, v)
        return (lambda x, *d: x.permute(*d))(o, 0, 2, 1, 3).reshape(B, Sq, Hq * Dh) @ wo

    def _B_ref(x, w_gate, w_up, w_down):
        g = torch.einsum("bsd,df->bsf", x, w_gate)
        u = torch.einsum("bsd,df->bsf", x, w_up)
        h = _sigmoid(g) * u
        return torch.einsum("bsf,fd->bsd", h, w_down)

    x = A_x
    xn = _layernorm(x, axis=-1)
    return x + _A_ref(xn, A_k_cache, A_v_cache, A_wq, A_wo) + _B_ref(xn, B_w_gate, B_w_up, B_w_down)
```

```asm
; @launch grid=(256,1,1) block=(448,1,1) lds=147456
.amdgcn_target "amdgcn-amd-amdhsa--gfx950"
.text
.globl parallel_sum__sliding_block_cached__glu_gated_glu__decode_kernel
.p2align 8
.type parallel_sum__sliding_block_cached__glu_gated_glu__decode_kernel,@function
parallel_sum__sliding_block_cached__glu_gated_glu__decode_kernel:
  s_cmp_ge_u32 s2, 256
  s_cbranch_scc1 Lexit
  s_load_dwordx16 s[4:19], s[0:1], 0
  s_load_dwordx8 s[20:27], s[0:1], 64
  s_getpc_b64 s[38:39]
Lpc:
  v_lshrrev_b32 v4, 6, v0
  s_bfe_u32 s33, s2, 0x10003
  s_mul_i32 s33, s33, 7
  v_add_u32 v4, s33, v4
  v_min_u32 v4, CODE_CHUNKS-1, v4
  v_lshlrev_b32 v4, 10, v4
  v_and_b32 v5, 63, v0
  v_lshl_add_u32 v4, v5, 4, v4
  s_sub_u32 s38, s38, Lpc-parallel_sum__sliding_block_cached__glu_gated_glu__decode_kernel
  s_subb_u32 s39, s39, 0
  global_load_dwordx4 v[212:215], v4, s[38:39]
  v_and_b32 v1, 63, v0
  v_lshrrev_b32 v4, 6, v0
  v_and_b32 v2, 15, v0
  v_bfe_u32 v3, v0, 4, 2
  v_readfirstlane_b32 s32, v4
  s_and_b32 s28, s2, 7
  s_lshr_b32 s29, s2, 3
  s_lshr_b32 s30, s29, 4
  s_getreg_b32 s42, hwreg(HW_REG_XCC_ID)
  s_and_b32 s42, s42, 15
  v_mov_b32 v11, 0
  v_mov_b32 v230, 0
  v_mov_b32 v229, 1
  s_mov_b32 s63, 0
  s_cmp_eq_u32 s32, 6
  s_cbranch_scc1 Lload
  s_cmp_ge_u32 s32, 4
  s_cbranch_scc1 Laux
  v_and_b32 v7, 3, v2
  v_lshlrev_b32 v7, 10, v7
  v_lshrrev_b32 v8, 2, v2
  v_lshl_add_u32 v7, v8, 8, v7
  s_lshl_b32 s33, s32, 12
  s_add_u32 s34, s33, 16384
  v_add_u32 v7, s34, v7
  v_xor_b32 v8, v3, v2
  v_xor_b32 v9, 0, v8
  v_lshl_add_u32 v52, v9, 4, v7
  v_xor_b32 v9, 4, v8
  v_lshl_add_u32 v53, v9, 4, v7
  v_xor_b32 v9, 8, v8
  v_lshl_add_u32 v54, v9, 4, v7
  v_xor_b32 v9, 12, v8
  v_lshl_add_u32 v55, v9, 4, v7
  s_add_u32 s34, s33, 81920
  v_lshlrev_b32 v56, 4, v1
  v_add_u32 v56, s34, v56
  s_waitcnt lgkmcnt(0)
  global_load_dword v18, v11, s[26:27] sc1
  s_lshl_b32 s33, s28, 19
  s_lshl_b32 s34, s29, 14
  s_add_u32 s33, s33, s34
  s_lshl_b32 s34, s32, 8
  s_add_u32 s33, s33, s34
  s_add_u32 s52, s12, s33
  s_addc_u32 s53, s13, 0
  s_cmp_lt_u32 s2, 224
  s_cselect_b32 s33, s2, 0
  s_lshl_b32 s33, s33, 13
  s_add_u32 s33, s33, s34
  s_add_u32 s54, s20, s33
  s_addc_u32 s55, s21, 0
  v_lshlrev_b32 v246, 10, v3
  v_lshl_add_u32 v246, v2, 4, v246
  v_add_u32 v247, 0x1000, v246
  s_lshl_b32 s33, s28, 1
  s_add_u32 s33, s33, s30
  s_lshl_b32 s33, s33, 14
  s_lshl_b32 s34, s32, 10
  s_add_u32 s33, s33, s34
  s_add_u32 s33, s33, 262144
  v_lshlrev_b32 v8, 4, v1
  v_add_u32 v240, s33, v8
  v_add_u32 v241, 0x1000, v240
  v_add_u32 v242, 0x2000, v240
  v_add_u32 v243, 0x3000, v240
  s_lshl_b32 s33, s28, 8
  s_add_u32 s33, s33, 32768
  v_and_b32 v8, 31, v1
  v_lshlrev_b32 v8, 3, v8
  v_add_u32 v245, s33, v8
  s_mov_b32 s33, 0xffff
  s_mov_b32 s34, 0xffff0000
  v_and_b32 v8, 1, v1
  v_cmp_eq_u32 vcc, 1, v8
  v_mov_b32 v9, s33
  v_mov_b32 v10, s34
  v_cndmask_b32 v9, v9, v10, vcc
  v_and_b32 v8, 2, v1
  v_cmp_eq_u32 vcc, 0, v8
  s_nop 1
  v_cndmask_b32 v12, 0, v9, vcc
  v_cmp_ne_u32 vcc, 0, v8
  s_nop 1
  v_cndmask_b32 v13, 0, v9, vcc
  v_bfe_u32 v8, v1, 1, 2
  v_cmp_eq_u32 vcc, 0, v8
  s_nop 1
  v_cndmask_b32 v14, 0, v9, vcc
  v_cmp_eq_u32 vcc, 1, v8
  s_nop 1
  v_cndmask_b32 v15, 0, v9, vcc
  v_cmp_eq_u32 vcc, 2, v8
  s_nop 1
  v_cndmask_b32 v16, 0, v9, vcc
  v_cmp_eq_u32 vcc, 3, v8
  s_nop 1
  v_cndmask_b32 v17, 0, v9, vcc
  s_lshl_b32 s33, s32, 11
  s_add_u32 s33, s33, 6144
  v_lshlrev_b32 v249, 9, v3
  v_lshl_add_u32 v249, v2, 5, v249
  v_add_u32 v249, s33, v249
  v_lshrrev_b32 v8, 3, v1
  v_lshlrev_b32 v8, 4, v8
  v_and_b32 v9, 1, v1
  v_lshl_add_u32 v8, v9, 3, v8
  v_bfe_u32 v9, v1, 1, 2
  v_add_u32 v8, v8, v9
  v_lshlrev_b32 v8, 2, v8
  s_lshl_b32 s33, s32, 9
  s_add_u32 s33, s33, 6144
  v_add_u32 v250, s33, v8
  v_add_u32 v251, 16, v250
  s_lshl_b32 s33, s28, 16
  s_lshl_b32 s34, s32, 14
  s_add_u32 s33, s33, s34
  s_lshl_b32 s34, s29, 6
  s_add_u32 s33, s33, s34
  s_add_u32 s33, s33, 1048576
  v_lshrrev_b32 v8, 3, v1
  v_lshlrev_b32 v8, 11, v8
  v_and_b32 v9, 7, v1
  v_lshl_add_u32 v8, v9, 3, v8
  v_add_u32 v252, s33, v8
  s_lshl_b32 s33, s28, 2
  s_lshr_b32 s34, s29, 3
  s_add_u32 s33, s33, s34
  s_lshl_b32 s33, s33, 9
  s_add_u32 s33, s33, 65536
  v_bfe_u32 v8, v1, 3, 1
  v_lshlrev_b32 v253, 8, v8
  v_lshl_add_u32 v253, v9, 4, v253
  v_add_u32 v253, s33, v253
  s_lshl_b32 s33, s28, 5
  s_add_u32 s33, s33, s29
  s_lshl_b32 s33, s33, 11
  s_add_u32 s33, s33, 1048576
  v_lshlrev_b32 v254, 10, v8
  v_lshl_add_u32 v254, v9, 6, v254
  v_lshl_add_u32 v254, v3, 4, v254
  v_add_u32 v254, s33, v254
  s_lshl_b32 s33, s28, 17
  s_lshl_b32 s34, s32, 14
  s_add_u32 s33, s33, s34
  s_lshl_b32 s34, s29, 7
  s_add_u32 s33, s33, s34
  s_add_u32 s33, s33, 2097152
  v_lshrrev_b32 v8, 1, v3
  v_lshlrev_b32 v8, 16, v8
  v_lshrrev_b32 v9, 2, v2
  v_lshl_add_u32 v8, v9, 12, v8
  v_and_b32 v9, 3, v2
  v_lshl_add_u32 v8, v9, 5, v8
  v_and_b32 v9, 1, v3
  v_lshl_add_u32 v8, v9, 4, v8
  v_add_u32 v255, s33, v8
  s_lshl_b32 s33, s28, 5
  s_add_u32 s33, s33, s29
  s_lshl_b32 s33, s33, 12
  s_lshl_b32 s34, s32, 5
  s_add_u32 s33, s33, s34
  s_add_u32 s33, s33, 2097152
  v_lshrrev_b32 v244, 1, v1
  v_lshlrev_b32 v244, 7, v244
  v_and_b32 v4, 1, v1
  v_lshl_add_u32 v244, v4, 4, v244
  v_add_u32 v244, s33, v244
  s_lshl_b32 s33, s29, 11
  s_lshl_b32 s34, s28, 8
  s_add_u32 s33, s33, s34
  s_lshl_b32 s34, s32, 6
  s_add_u32 s33, s33, s34
  s_add_u32 s33, s33, 3145728
  v_lshlrev_b32 v231, 5, v4
  v_lshl_add_u32 v231, v3, 3, v231
  v_add_u32 v231, s33, v231
  v_mov_b32 v28, 0
  v_mov_b32 v29, 0
  v_mov_b32 v30, 0
  v_mov_b32 v31, 0
  v_lshrrev_b32 v8, 2, v2
  v_lshlrev_b32 v8, 8, v8
  v_lshl_add_u32 v8, v3, 4, v8
  v_add_u32 v8, 4096, v8
  v_lshlrev_b32 v9, 4, v3
  v_add_u32 v9, 5504, v9
  v_and_b32 v10, 3, v2
  v_cmp_eq_u32 vcc, 0, v10
  s_nop 1
  v_cndmask_b32 v57, v9, v8, vcc
  v_cmp_eq_u32 vcc, 1, v10
  s_nop 1
  v_cndmask_b32 v58, v9, v8, vcc
  v_cmp_eq_u32 vcc, 2, v10
  s_nop 1
  v_cndmask_b32 v59, v9, v8, vcc
  v_cmp_eq_u32 vcc, 3, v10
  s_nop 1
  v_cndmask_b32 v60, v9, v8, vcc
  s_barrier
  s_waitcnt vmcnt(0)
  v_readfirstlane_b32 s31, v18
  s_add_u32 s31, s31, 0x9e3779b9
  s_cmp_ge_u32 s63, 8
  s_cbranch_scc1 Lwpd_1
  s_mov_b32 s37, 400000
Lsp_2:
  ds_read_b32 v11, v230 offset:5440
  s_sub_u32 s37, s37, 1
  s_cbranch_scc1 Lspx_3
  s_waitcnt lgkmcnt(0)
  v_readfirstlane_b32 s63, v11
  s_cmp_lt_u32 s63, 8
  s_cbranch_scc1 Lsp_2
Lspx_3:
  s_waitcnt lgkmcnt(0)
Lwpd_1:
  global_load_dwordx4 v[32:35], v240, s[26:27] sc1
  global_load_dwordx4 v[36:39], v241, s[26:27] sc1
  global_load_dwordx4 v[40:43], v242, s[26:27] sc1
  global_load_dwordx4 v[44:47], v243, s[26:27] sc1
  global_load_dwordx2 v[24:25], v245, s[26:27] sc1
  ds_read_b32 v11, v230 offset:5440
  s_mov_b32 s35, 0
  s_waitcnt lgkmcnt(0)
  v_readfirstlane_b32 s63, v11
  s_cmp_lt_u32 s63, 16
  s_cbranch_scc1 Lk1_4
  s_mov_b32 s35, 1
  ds_read_b128 v[64:67], v52 offset:0
  ds_read_b128 v[68:71], v53 offset:0
  ds_read_b128 v[72:75], v54 offset:0
  ds_read_b128 v[76:79], v55 offset:0
  ds_read_b128 v[80:83], v52 offset:16384
  ds_read_b128 v[84:87], v53 offset:16384
  ds_read_b128 v[88:91], v54 offset:16384
  ds_read_b128 v[92:95], v55 offset:16384
  ds_read_b128 v[96:99], v52 offset:32768
  ds_read_b128 v[100:103], v53 offset:32768
  ds_read_b128 v[104:107], v54 offset:32768
  ds_read_b128 v[108:111], v55 offset:32768
  ds_read_b128 v[112:115], v52 offset:49152
  ds_read_b128 v[116:119], v53 offset:49152
  ds_read_b128 v[120:123], v54 offset:49152
  ds_read_b128 v[124:127], v55 offset:49152
Lk1_4:
  s_waitcnt vmcnt(0)
  v_xor_b32 v10, s31, v33
  v_xor_b32 v11, s31, v35
  v_xor_b32 v238, s31, v37
  v_or3_b32 v10, v10, v11, v238
  v_xor_b32 v11, s31, v39
  v_xor_b32 v238, s31, v41
  v_or3_b32 v10, v10, v11, v238
  v_xor_b32 v11, s31, v43
  v_xor_b32 v238, s31, v45
  v_or3_b32 v10, v10, v11, v238
  v_xor_b32 v11, s31, v47
  v_xor_b32 v238, s31, v25
  v_or3_b32 v10, v10, v11, v238
  v_cmp_ne_u32 vcc, 0, v10
  s_cbranch_vccz Lq_ok_7
  s_mov_b32 s37, 400000
Lq_retry_6:
  s_mov_b64 exec, vcc
  global_load_dwordx4 v[32:35], v240, s[26:27] sc1
  global_load_dwordx4 v[36:39], v241, s[26:27] sc1
  global_load_dwordx4 v[40:43], v242, s[26:27] sc1
  global_load_dwordx4 v[44:47], v243, s[26:27] sc1
  global_load_dwordx2 v[24:25], v245, s[26:27] sc1
  s_waitcnt vmcnt(0)
  v_xor_b32 v10, s31, v33
  v_xor_b32 v11, s31, v35
  v_xor_b32 v238, s31, v37
  v_or3_b32 v10, v10, v11, v238
  v_xor_b32 v11, s31, v39
  v_xor_b32 v238, s31, v41
  v_or3_b32 v10, v10, v11, v238
  v_xor_b32 v11, s31, v43
  v_xor_b32 v238, s31, v45
  v_or3_b32 v10, v10, v11, v238
  v_xor_b32 v11, s31, v47
  v_xor_b32 v238, s31, v25
  v_or3_b32 v10, v10, v11, v238
  v_cmp_ne_u32 vcc, 0, v10
  s_cbranch_vccz Lq_ok_7_x
  s_sub_u32 s37, s37, 1
  s_cmp_lg_u32 s37, 0
  s_cbranch_scc1 Lq_retry_6
Lq_ok_7_x:
  s_mov_b64 exec, -1
Lq_ok_7:
  v_add_f32 v32, v32, v36
  v_add_f32 v34, v34, v38
  v_add_f32 v40, v40, v44
  v_add_f32 v42, v42, v46
  v_add_f32 v32, v32, v40
  v_add_f32 v34, v34, v42
  v_cvt_pk_bf16_f32 v32, v32, v34
  v_lshlrev_b32 v8, 2, v0
  ds_write_b32 v8, v32 offset:4096
  v_cmp_ne_u32 vcc, s42, v24
  s_cmp_eq_u64 vcc, 0
  s_cselect_b32 s43, 1, 0
  v_lshrrev_b32 v6, 2, v2
  v_lshlrev_b32 v6, 4, v6
  s_lshl_b32 s33, s32, 2
  v_add_u32 v7, s33, v6
  s_waitcnt lgkmcnt(0)
  s_mov_b64 exec, 1
  ds_add_u32 v230, v229 offset:5444
  s_mov_b64 exec, -1
  s_mov_b32 s37, 400000
Lsp_8:
  ds_read_b32 v11, v230 offset:5444
  s_sub_u32 s37, s37, 1
  s_cbranch_scc1 Lspx_9
  s_waitcnt lgkmcnt(0)
  v_readfirstlane_b32 s36, v11
  s_cmp_lt_u32 s36, 4
  s_cbranch_scc1 Lsp_8
Lspx_9:
  s_waitcnt lgkmcnt(0)
  s_cmp_eq_u32 s35, 1
  s_cbranch_scc1 Lk2_5
  s_cmp_ge_u32 s63, 16
  s_cbranch_scc1 Lwpd_10
  s_mov_b32 s37, 400000
Lsp_11:
  ds_read_b32 v11, v230 offset:5440
  s_sub_u32 s37, s37, 1
  s_cbranch_scc1 Lspx_12
  s_waitcnt lgkmcnt(0)
  v_readfirstlane_b32 s63, v11
  s_cmp_lt_u32 s63, 16
  s_cbranch_scc1 Lsp_11
Lspx_12:
  s_waitcnt lgkmcnt(0)
Lwpd_10:
  ds_read_b128 v[64:67], v52 offset:0
  ds_read_b128 v[68:71], v53 offset:0
  ds_read_b128 v[72:75], v54 offset:0
  ds_read_b128 v[76:79], v55 offset:0
  ds_read_b128 v[80:83], v52 offset:16384
  ds_read_b128 v[84:87], v53 offset:16384
  ds_read_b128 v[88:91], v54 offset:16384
  ds_read_b128 v[92:95], v55 offset:16384
  ds_read_b128 v[96:99], v52 offset:32768
  ds_read_b128 v[100:103], v53 offset:32768
  ds_read_b128 v[104:107], v54 offset:32768
  ds_read_b128 v[108:111], v55 offset:32768
  ds_read_b128 v[112:115], v52 offset:49152
  ds_read_b128 v[116:119], v53 offset:49152
  ds_read_b128 v[120:123], v54 offset:49152
  ds_read_b128 v[124:127], v55 offset:49152
Lk2_5:
  ds_read_b128 v[128:131], v57 offset:0
  ds_read_b128 v[132:135], v57 offset:64
  ds_read_b128 v[136:139], v57 offset:128
  ds_read_b128 v[140:143], v57 offset:192
  ds_read_b128 v[144:147], v58 offset:0
  ds_read_b128 v[148:151], v58 offset:64
  ds_read_b128 v[152:155], v58 offset:128
  ds_read_b128 v[156:159], v58 offset:192
  ds_read_b128 v[160:163], v59 offset:0
  ds_read_b128 v[164:167], v59 offset:64
  ds_read_b128 v[168:171], v59 offset:128
  ds_read_b128 v[172:175], v59 offset:192
  ds_read_b128 v[176:179], v60 offset:0
  ds_read_b128 v[180:183], v60 offset:64
  ds_read_b128 v[184:187], v60 offset:128
  ds_read_b128 v[188:191], v60 offset:192
  s_waitcnt lgkmcnt(12)
  v_mfma_f32_16x16x32_bf16 v[48:51], v[64:67], v[128:131], 0
  v_mfma_f32_16x16x32_bf16 v[48:51], v[68:71], v[132:135], v[48:51]
  v_mfma_f32_16x16x32_bf16 v[48:51], v[72:75], v[136:139], v[48:51]
  v_mfma_f32_16x16x32_bf16 v[48:51], v[76:79], v[140:143], v[48:51]
  s_waitcnt lgkmcnt(8)
  v_mfma_f32_16x16x32_bf16 v[48:51], v[80:83], v[144:147], v[48:51]
  v_mfma_f32_16x16x32_bf16 v[48:51], v[84:87], v[148:151], v[48:51]
  v_mfma_f32_16x16x32_bf16 v[48:51], v[88:91], v[152:155], v[48:51]
  v_mfma_f32_16x16x32_bf16 v[48:51], v[92:95], v[156:159], v[48:51]
  s_waitcnt lgkmcnt(4)
  v_mfma_f32_16x16x32_bf16 v[48:51], v[96:99], v[160:163], v[48:51]
  v_mfma_f32_16x16x32_bf16 v[48:51], v[100:103], v[164:167], v[48:51]
  v_mfma_f32_16x16x32_bf16 v[48:51], v[104:107], v[168:171], v[48:51]
  v_mfma_f32_16x16x32_bf16 v[48:51], v[108:111], v[172:175], v[48:51]
  s_waitcnt lgkmcnt(0)
  v_mfma_f32_16x16x32_bf16 v[48:51], v[112:115], v[176:179], v[48:51]
  v_mfma_f32_16x16x32_bf16 v[48:51], v[116:119], v[180:183], v[48:51]
  v_mfma_f32_16x16x32_bf16 v[48:51], v[120:123], v[184:187], v[48:51]
  v_mfma_f32_16x16x32_bf16 v[48:51], v[124:127], v[188:191], v[48:51]
  s_mov_b32 s38, 0x3db504f3
  s_mov_b32 s39, 0x3db504f3
  s_nop 5
  v_cvt_pk_bf16_f32 v232, v48, v49
  v_cvt_pk_bf16_f32 v233, v50, v51
  v_lshlrev_b32 v48, 16, v232
  v_and_b32 v49, 0xffff0000, v232
  v_lshlrev_b32 v50, 16, v233
  v_and_b32 v51, 0xffff0000, v233
  v_pk_mul_f32 v[48:49], v[48:49], s[38:39]
  v_pk_mul_f32 v[50:51], v[50:51], s[38:39]
  v_cvt_pk_bf16_f32 v232, v48, v49
  v_cvt_pk_bf16_f32 v233, v50, v51
  v_lshlrev_b32 v48, 16, v232
  v_and_b32 v49, 0xffff0000, v232
  v_lshlrev_b32 v50, 16, v233
  v_and_b32 v51, 0xffff0000, v233
  v_max3_f32 v4, v48, v49, v50
  v_max_f32 v4, v4, v51
  s_nop 1
  v_max_f32_dpp v4, v4, v4 quad_perm:[1,0,3,2] row_mask:0xf bank_mask:0xf
  s_nop 1
  v_max_f32_dpp v4, v4, v4 quad_perm:[2,3,0,1] row_mask:0xf bank_mask:0xf
  v_mov_b32 v5, v4
  s_nop 1
  v_permlane16_swap_b32 v4, v5
  v_max_f32 v4, v4, v5
  v_mov_b32 v5, v4
  s_nop 1
  v_permlane32_swap_b32 v4, v5
  v_max_f32 v4, v4, v5
  ds_write_b32 v7, v4 offset:5120
  s_waitcnt lgkmcnt(0)
  s_mov_b64 exec, 1
  ds_add_u32 v230, v229 offset:5448
  s_mov_b64 exec, -1
  s_mov_b32 s37, 400000
Lsp_13:
  ds_read_b32 v11, v230 offset:5448
  s_sub_u32 s37, s37, 1
  s_cbranch_scc1 Lspx_14
  s_waitcnt lgkmcnt(0)
  v_readfirstlane_b32 s36, v11
  s_cmp_lt_u32 s36, 4
  s_cbranch_scc1 Lsp_13
Lspx_14:
  s_waitcnt lgkmcnt(0)
  ds_read_b128 v[232:235], v6 offset:5120
  s_mov_b32 s38, 0x3fb8aa3b
  s_waitcnt lgkmcnt(0)
  v_max3_f32 v4, v232, v233, v234
  v_max_f32 v4, v4, v235
  v_mul_f32 v4, s38, v4
  v_fma_f32 v48, v48, s38, -v4
  v_fma_f32 v49, v49, s38, -v4
  v_fma_f32 v50, v50, s38, -v4
  v_fma_f32 v51, v51, s38, -v4
  v_exp_f32 v48, v48
  v_exp_f32 v49, v49
  v_exp_f32 v50, v50
  v_exp_f32 v51, v51
  s_nop 0
  v_add_f32 v232, v48, v49
  v_add_f32 v233, v50, v51
  v_cvt_pk_bf16_f32 v48, v48, v48
  v_cvt_pk_bf16_f32 v49, v49, v49
  v_cvt_pk_bf16_f32 v50, v50, v50
  v_cvt_pk_bf16_f32 v51, v51, v51
  v_add_f32 v5, v232, v233
  v_and_b32_dpp v64, v48, v12 quad_perm:[0,0,0,0] row_mask:0xf bank_mask:0xf
  v_and_b32_dpp v65, v48, v13 quad_perm:[0,0,0,0] row_mask:0xf bank_mask:0xf
  v_and_b32_dpp v66, v49, v12 quad_perm:[0,0,0,0] row_mask:0xf bank_mask:0xf
  v_and_b32_dpp v67, v49, v13 quad_perm:[0,0,0,0] row_mask:0xf bank_mask:0xf
  v_and_b32_dpp v68, v50, v12 quad_perm:[0,0,0,0] row_mask:0xf bank_mask:0xf
  v_and_b32_dpp v69, v50, v13 quad_perm:[0,0,0,0] row_mask:0xf bank_mask:0xf
  v_and_b32_dpp v70, v51, v12 quad_perm:[0,0,0,0] row_mask:0xf bank_mask:0xf
  v_and_b32_dpp v71, v51, v13 quad_perm:[0,0,0,0] row_mask:0xf bank_mask:0xf
  v_add_f32_dpp v5, v5, v5 quad_perm:[1,0,3,2] row_mask:0xf bank_mask:0xf
  v_and_b32_dpp v72, v48, v12 quad_perm:[1,1,1,1] row_mask:0xf bank_mask:0xf
  v_and_b32_dpp v73, v48, v13 quad_perm:[1,1,1,1] row_mask:0xf bank_mask:0xf
  v_and_b32_dpp v74, v49, v12 quad_perm:[1,1,1,1] row_mask:0xf bank_mask:0xf
  v_and_b32_dpp v75, v49, v13 quad_perm:[1,1,1,1] row_mask:0xf bank_mask:0xf
  v_and_b32_dpp v76, v50, v12 quad_perm:[1,1,1,1] row_mask:0xf bank_mask:0xf
  v_and_b32_dpp v77, v50, v13 quad_perm:[1,1,1,1] row_mask:0xf bank_mask:0xf
  v_and_b32_dpp v78, v51, v12 quad_perm:[1,1,1,1] row_mask:0xf bank_mask:0xf
  v_and_b32_dpp v79, v51, v13 quad_perm:[1,1,1,1] row_mask:0xf bank_mask:0xf
  v_add_f32_dpp v5, v5, v5 quad_perm:[2,3,0,1] row_mask:0xf bank_mask:0xf
  v_and_b32_dpp v80, v48, v12 quad_perm:[2,2,2,2] row_mask:0xf bank_mask:0xf
  v_and_b32_dpp v81, v48, v13 quad_perm:[2,2,2,2] row_mask:0xf bank_mask:0xf
  v_and_b32_dpp v82, v49, v12 quad_perm:[2,2,2,2] row_mask:0xf bank_mask:0xf
  v_and_b32_dpp v83, v49, v13 quad_perm:[2,2,2,2] row_mask:0xf bank_mask:0xf
  v_and_b32_dpp v84, v50, v12 quad_perm:[2,2,2,2] row_mask:0xf bank_mask:0xf
  v_and_b32_dpp v85, v50, v13 quad_perm:[2,2,2,2] row_mask:0xf bank_mask:0xf
  v_and_b32_dpp v86, v51, v12 quad_perm:[2,2,2,2] row_mask:0xf bank_mask:0xf
  v_and_b32_dpp v87, v51, v13 quad_perm:[2,2,2,2] row_mask:0xf bank_mask:0xf
  v_and_b32_dpp v88, v48, v12 quad_perm:[3,3,3,3] row_mask:0xf bank_mask:0xf
  v_and_b32_dpp v89, v48, v13 quad_perm:[3,3,3,3] row_mask:0xf bank_mask:0xf
  v_and_b32_dpp v90, v49, v12 quad_perm:[3,3,3,3] row_mask:0xf bank_mask:0xf
  v_and_b32_dpp v91, v49, v13 quad_perm:[3,3,3,3] row_mask:0xf bank_mask:0xf
  v_and_b32_dpp v92, v50, v12 quad_perm:[3,3,3,3] row_mask:0xf bank_mask:0xf
  v_and_b32_dpp v93, v50, v13 quad_perm:[3,3,3,3] row_mask:0xf bank_mask:0xf
  v_and_b32_dpp v94, v51, v12 quad_perm:[3,3,3,3] row_mask:0xf bank_mask:0xf
  v_and_b32_dpp v95, v51, v13 quad_perm:[3,3,3,3] row_mask:0xf bank_mask:0xf
  v_mov_b32 v8, v5
  s_nop 1
  v_permlane16_swap_b32 v5, v8
  v_add_f32 v5, v5, v8
  v_mov_b32 v8, v5
  s_nop 1
  v_permlane32_swap_b32 v5, v8
  v_add_f32 v5, v5, v8
  ds_write_b32 v7, v5 offset:5184
  s_lshl_b32 s33, s32, 4
  v_mov_b32 v228, s33
  s_lshl_b32 s33, s28, 2
  s_add_u32 s33, s33, s32
  s_lshl_b32 s33, s33, 9
  s_lshl_b32 s34, s29, 4
  s_add_u32 s33, s33, s34
  s_add_u32 s33, s33, 65536
  v_mov_b32 v19, s33
  s_waitcnt lgkmcnt(0)
  s_mov_b64 exec, 1
  ds_add_u32 v230, v229 offset:5452
  s_mov_b64 exec, -1
  s_mov_b32 s37, 400000
Lsp_15:
  ds_read_b32 v11, v230 offset:5452
  s_sub_u32 s37, s37, 1
  s_cbranch_scc1 Lspx_16
  s_waitcnt lgkmcnt(0)
  v_readfirstlane_b32 s36, v11
  s_cmp_lt_u32 s36, 4
  s_cbranch_scc1 Lsp_15
Lspx_16:
  s_waitcnt lgkmcnt(0)
  ds_read_b128 v[232:235], v228 offset:5184
  ds_read_b128 v[236:239], v228 offset:5120
  s_waitcnt lgkmcnt(0)
  v_add_f32 v232, v232, v233
  v_add_f32 v234, v234, v235
  v_max3_f32 v236, v236, v237, v238
  v_add_f32 v234, v232, v234
  v_max_f32 v232, v236, v239
  v_mul_f32 v232, s38, v232
  v_mov_b32 v233, s31
  v_mov_b32 v235, s31
  s_mov_b64 exec, 1
  s_cmp_eq_u32 s43, 0
  s_cbranch_scc1 Lsts_17
  global_store_dwordx4 v19, v[232:235], s[26:27]
  s_branch Lste_18
Lsts_17:
  global_store_dwordx4 v19, v[232:235], s[26:27] sc1
Lste_18:
  s_mov_b64 exec, -1
  s_cmp_ge_u32 s2, 224
  s_cbranch_scc1 Lhwd_20
  s_mov_b32 s37, 400000
Lsp_21:
  ds_read_b32 v11, v230 offset:5456
  s_sub_u32 s37, s37, 1
  s_cbranch_scc1 Lspx_22
  s_waitcnt lgkmcnt(0)
  v_readfirstlane_b32 s36, v11
  s_cmp_eq_u32 s36, 0
  s_cbranch_scc1 Lsp_21
Lspx_22:
  s_waitcnt lgkmcnt(0)
Lhwd_20:
  v_bfe_u32 v9, v1, 3, 1
  v_lshlrev_b32 v9, 6, v9
  v_lshl_add_u32 v9, v3, 4, v9
  ds_read_b64 v[216:217], v9 offset:5248
  v_mov_b32 v5, s31
  s_waitcnt lgkmcnt(0)
  v_and_b32 v220, v216, v14
  v_and_b32 v221, v216, v15
  v_and_b32 v222, v216, v16
  v_and_b32 v223, v216, v17
  v_and_b32 v224, v217, v14
  v_and_b32 v225, v217, v15
  v_and_b32 v226, v217, v16
  v_and_b32 v227, v217, v17
  s_cmp_lg_u32 s32, 0
  s_cbranch_scc1 Lpt_23
  global_load_dwordx4 v[192:195], v253, s[26:27] sc1
  global_load_dwordx4 v[196:199], v253, s[26:27] offset:128 sc1
  global_load_dwordx4 v[200:203], v254, s[26:27] sc1
  global_load_dwordx4 v[204:207], v254, s[26:27] offset:512 sc1
  v_lshlrev_b32 v8, 4, v1
  v_and_b32 v9, 0xfffff000, v244
  v_add_u32 v8, v9, v8
  global_load_dwordx4 v[192:195], v8, s[26:27] sc1
  global_load_dwordx4 v[196:199], v8, s[26:27] offset:1024 sc1
  global_load_dwordx4 v[200:203], v8, s[26:27] offset:2048 sc1
  global_load_dwordx4 v[204:207], v8, s[26:27] offset:3072 sc1
  s_and_b32 s33, s29, 7
  s_cmp_lg_u32 s33, s28
  s_cbranch_scc1 Lpt_23
  s_lshl_b32 s33, s29, 11
  s_add_u32 s33, s33, 3145728
  v_lshlrev_b32 v8, 4, v1
  v_add_u32 v8, s33, v8
  global_load_dwordx4 v[192:195], v8, s[26:27] sc1
  global_load_dwordx4 v[196:199], v8, s[26:27] offset:1024 sc1
Lpt_23:
  global_load_dwordx4 v[32:35], v253, s[26:27] sc1
  global_load_dwordx4 v[36:39], v253, s[26:27] offset:128 sc1
  global_load_dwordx4 v[208:211], v246, s[54:55] nt
  global_load_dwordx4 v[212:215], v247, s[54:55] nt
  global_load_dwordx4 v[192:195], v246, s[52:53] nt
  global_load_dwordx4 v[196:199], v247, s[52:53] nt
  v_add_u32 v248, 0x2000, v246
  global_load_dwordx4 v[200:203], v248, s[52:53] nt
  v_add_u32 v248, 0x3000, v246
  global_load_dwordx4 v[204:207], v248, s[52:53] nt
  s_add_u32 s35, s32, 17
  s_cmp_ge_u32 s63, s35
  s_cbranch_scc1 Lwpd_25
  s_mov_b32 s37, 400000
Lsp_26:
  ds_read_b32 v11, v230 offset:5440
  s_sub_u32 s37, s37, 1
  s_cbranch_scc1 Lspx_27
  s_waitcnt lgkmcnt(0)
  v_readfirstlane_b32 s63, v11
  s_cmp_lt_u32 s63, s35
  s_cbranch_scc1 Lsp_26
Lspx_27:
  s_waitcnt lgkmcnt(0)
Lwpd_25:
  ds_read_b128 v[128:131], v56 offset:0
  ds_read_b128 v[132:135], v56 offset:1024
  ds_read_b128 v[136:139], v56 offset:2048
  ds_read_b128 v[140:143], v56 offset:3072
  s_add_u32 s35, s35, 4
  s_cmp_ge_u32 s63, s35
  s_cbranch_scc0 Lpvs_28
  ds_read_b128 v[144:147], v56 offset:16384
  ds_read_b128 v[148:151], v56 offset:17408
  ds_read_b128 v[152:155], v56 offset:18432
  ds_read_b128 v[156:159], v56 offset:19456
  s_waitcnt lgkmcnt(7)
  v_mfma_f32_16x16x16_bf16 v[20:23], v[64:65], v[128:129], 0
  v_mfma_f32_16x16x16_bf16 v[24:27], v[64:65], v[130:131], 0
  s_waitcnt lgkmcnt(6)
  v_mfma_f32_16x16x16_bf16 v[20:23], v[66:67], v[132:133], v[20:23]
  v_mfma_f32_16x16x16_bf16 v[24:27], v[66:67], v[134:135], v[24:27]
  s_waitcnt lgkmcnt(5)
  v_mfma_f32_16x16x16_bf16 v[20:23], v[68:69], v[136:137], v[20:23]
  v_mfma_f32_16x16x16_bf16 v[24:27], v[68:69], v[138:139], v[24:27]
  s_waitcnt lgkmcnt(4)
  v_mfma_f32_16x16x16_bf16 v[20:23], v[70:71], v[140:141], v[20:23]
  v_mfma_f32_16x16x16_bf16 v[24:27], v[70:71], v[142:143], v[24:27]
  s_branch Lpvj_29
Lpvs_28:
  s_waitcnt lgkmcnt(3)
  v_mfma_f32_16x16x16_bf16 v[20:23], v[64:65], v[128:129], 0
  v_mfma_f32_16x16x16_bf16 v[24:27], v[64:65], v[130:131], 0
  s_waitcnt lgkmcnt(2)
  v_mfma_f32_16x16x16_bf16 v[20:23], v[66:67], v[132:133], v[20:23]
  v_mfma_f32_16x16x16_bf16 v[24:27], v[66:67], v[134:135], v[24:27]
  s_waitcnt lgkmcnt(1)
  v_mfma_f32_16x16x16_bf16 v[20:23], v[68:69], v[136:137], v[20:23]
  v_mfma_f32_16x16x16_bf16 v[24:27], v[68:69], v[138:139], v[24:27]
  s_waitcnt lgkmcnt(0)
  v_mfma_f32_16x16x16_bf16 v[20:23], v[70:71], v[140:141], v[20:23]
  v_mfma_f32_16x16x16_bf16 v[24:27], v[70:71], v[142:143], v[24:27]
  s_cmp_ge_u32 s63, s35
  s_cbranch_scc1 Lwpd_30
  s_mov_b32 s37, 400000
Lsp_31:
  ds_read_b32 v11, v230 offset:5440
  s_sub_u32 s37, s37, 1
  s_cbranch_scc1 Lspx_32
  s_waitcnt lgkmcnt(0)
  v_readfirstlane_b32 s63, v11
  s_cmp_lt_u32 s63, s35
  s_cbranch_scc1 Lsp_31
Lspx_32:
  s_waitcnt lgkmcnt(0)
Lwpd_30:
  ds_read_b128 v[144:147], v56 offset:16384
  ds_read_b128 v[148:151], v56 offset:17408
  ds_read_b128 v[152:155], v56 offset:18432
  ds_read_b128 v[156:159], v56 offset:19456
Lpvj_29:
  s_add_u32 s35, s35, 4
  s_cmp_ge_u32 s63, s35
  s_cbranch_scc0 Lpvs_33
  ds_read_b128 v[160:163], v56 offset:32768
  ds_read_b128 v[164:167], v56 offset:33792
  ds_read_b128 v[168:171], v56 offset:34816
  ds_read_b128 v[172:175], v56 offset:35840
  s_waitcnt lgkmcnt(7)
  v_mfma_f32_16x16x16_bf16 v[20:23], v[72:73], v[144:145], v[20:23]
  v_mfma_f32_16x16x16_bf16 v[24:27], v[72:73], v[146:147], v[24:27]
  s_waitcnt lgkmcnt(6)
  v_mfma_f32_16x16x16_bf16 v[20:23], v[74:75], v[148:149], v[20:23]
  v_mfma_f32_16x16x16_bf16 v[24:27], v[74:75], v[150:151], v[24:27]
  s_waitcnt lgkmcnt(5)
  v_mfma_f32_16x16x16_bf16 v[20:23], v[76:77], v[152:153], v[20:23]
  v_mfma_f32_16x16x16_bf16 v[24:27], v[76:77], v[154:155], v[24:27]
  s_waitcnt lgkmcnt(4)
  v_mfma_f32_16x16x16_bf16 v[20:23], v[78:79], v[156:157], v[20:23]
  v_mfma_f32_16x16x16_bf16 v[24:27], v[78:79], v[158:159], v[24:27]
  s_branch Lpvj_34
Lpvs_33:
  s_waitcnt lgkmcnt(3)
  v_mfma_f32_16x16x16_bf16 v[20:23], v[72:73], v[144:145], v[20:23]
  v_mfma_f32_16x16x16_bf16 v[24:27], v[72:73], v[146:147], v[24:27]
  s_waitcnt lgkmcnt(2)
  v_mfma_f32_16x16x16_bf16 v[20:23], v[74:75], v[148:149], v[20:23]
  v_mfma_f32_16x16x16_bf16 v[24:27], v[74:75], v[150:151], v[24:27]
  s_waitcnt lgkmcnt(1)
  v_mfma_f32_16x16x16_bf16 v[20:23], v[76:77], v[152:153], v[20:23]
  v_mfma_f32_16x16x16_bf16 v[24:27], v[76:77], v[154:155], v[24:27]
  s_waitcnt lgkmcnt(0)
  v_mfma_f32_16x16x16_bf16 v[20:23], v[78:79], v[156:157], v[20:23]
  v_mfma_f32_16x16x16_bf16 v[24:27], v[78:79], v[158:159], v[24:27]
  s_cmp_ge_u32 s63, s35
  s_cbranch_scc1 Lwpd_35
  s_mov_b32 s37, 400000
Lsp_36:
  ds_read_b32 v11, v230 offset:5440
  s_sub_u32 s37, s37, 1
  s_cbranch_scc1 Lspx_37
  s_waitcnt lgkmcnt(0)
  v_readfirstlane_b32 s63, v11
  s_cmp_lt_u32 s63, s35
  s_cbranch_scc1 Lsp_36
Lspx_37:
  s_waitcnt lgkmcnt(0)
Lwpd_35:
  ds_read_b128 v[160:163], v56 offset:32768
  ds_read_b128 v[164:167], v56 offset:33792
  ds_read_b128 v[168:171], v56 offset:34816
  ds_read_b128 v[172:175], v56 offset:35840
Lpvj_34:
  s_add_u32 s35, s35, 4
  s_cmp_ge_u32 s63, s35
  s_cbranch_scc0 Lpvs_38
  ds_read_b128 v[176:179], v56 offset:49152
  ds_read_b128 v[180:183], v56 offset:50176
  ds_read_b128 v[184:187], v56 offset:51200
  ds_read_b128 v[188:191], v56 offset:52224
  s_waitcnt lgkmcnt(7)
  v_mfma_f32_16x16x16_bf16 v[20:23], v[80:81], v[160:161], v[20:23]
  v_mfma_f32_16x16x16_bf16 v[24:27], v[80:81], v[162:163], v[24:27]
  s_waitcnt lgkmcnt(6)
  v_mfma_f32_16x16x16_bf16 v[20:23], v[82:83], v[164:165], v[20:23]
  v_mfma_f32_16x16x16_bf16 v[24:27], v[82:83], v[166:167], v[24:27]
  s_waitcnt lgkmcnt(5)
  v_mfma_f32_16x16x16_bf16 v[20:23], v[84:85], v[168:169], v[20:23]
  v_mfma_f32_16x16x16_bf16 v[24:27], v[84:85], v[170:171], v[24:27]
  s_waitcnt lgkmcnt(4)
  v_mfma_f32_16x16x16_bf16 v[20:23], v[86:87], v[172:173], v[20:23]
  v_mfma_f32_16x16x16_bf16 v[24:27], v[86:87], v[174:175], v[24:27]
  s_branch Lpvj_39
Lpvs_38:
  s_waitcnt lgkmcnt(3)
  v_mfma_f32_16x16x16_bf16 v[20:23], v[80:81], v[160:161], v[20:23]
  v_mfma_f32_16x16x16_bf16 v[24:27], v[80:81], v[162:163], v[24:27]
  s_waitcnt lgkmcnt(2)
  v_mfma_f32_16x16x16_bf16 v[20:23], v[82:83], v[164:165], v[20:23]
  v_mfma_f32_16x16x16_bf16 v[24:27], v[82:83], v[166:167], v[24:27]
  s_waitcnt lgkmcnt(1)
  v_mfma_f32_16x16x16_bf16 v[20:23], v[84:85], v[168:169], v[20:23]
  v_mfma_f32_16x16x16_bf16 v[24:27], v[84:85], v[170:171], v[24:27]
  s_waitcnt lgkmcnt(0)
  v_mfma_f32_16x16x16_bf16 v[20:23], v[86:87], v[172:173], v[20:23]
  v_mfma_f32_16x16x16_bf16 v[24:27], v[86:87], v[174:175], v[24:27]
  s_cmp_ge_u32 s63, s35
  s_cbranch_scc1 Lwpd_40
  s_mov_b32 s37, 400000
Lsp_41:
  ds_read_b32 v11, v230 offset:5440
  s_sub_u32 s37, s37, 1
  s_cbranch_scc1 Lspx_42
  s_waitcnt lgkmcnt(0)
  v_readfirstlane_b32 s63, v11
  s_cmp_lt_u32 s63, s35
  s_cbranch_scc1 Lsp_41
Lspx_42:
  s_waitcnt lgkmcnt(0)
Lwpd_40:
  ds_read_b128 v[176:179], v56 offset:49152
  ds_read_b128 v[180:183], v56 offset:50176
  ds_read_b128 v[184:187], v56 offset:51200
  ds_read_b128 v[188:191], v56 offset:52224
Lpvj_39:
  s_waitcnt lgkmcnt(3)
  v_mfma_f32_16x16x16_bf16 v[20:23], v[88:89], v[176:177], v[20:23]
  v_mfma_f32_16x16x16_bf16 v[24:27], v[88:89], v[178:179], v[24:27]
  s_waitcnt lgkmcnt(2)
  v_mfma_f32_16x16x16_bf16 v[20:23], v[90:91], v[180:181], v[20:23]
  v_mfma_f32_16x16x16_bf16 v[24:27], v[90:91], v[182:183], v[24:27]
  s_waitcnt lgkmcnt(1)
  v_mfma_f32_16x16x16_bf16 v[20:23], v[92:93], v[184:185], v[20:23]
  v_mfma_f32_16x16x16_bf16 v[24:27], v[92:93], v[186:187], v[24:27]
  s_waitcnt lgkmcnt(0)
  v_mfma_f32_16x16x16_bf16 v[20:23], v[94:95], v[188:189], v[20:23]
  v_mfma_f32_16x16x16_bf16 v[24:27], v[94:95], v[190:191], v[24:27]
  s_nop 7
  ds_write_b128 v249, v[20:23]
  ds_write_b128 v249, v[24:27] offset:16
  s_waitcnt lgkmcnt(0)
  s_barrier
  ds_read2st64_b32 v[232:233], v250 offset0:0 offset1:8
  ds_read2st64_b32 v[234:235], v250 offset0:16 offset1:24
  ds_read2st64_b32 v[236:237], v251 offset0:0 offset1:8
  ds_read2st64_b32 v[238:239], v251 offset0:16 offset1:24
  s_waitcnt lgkmcnt(2)
  v_pk_add_f32 v[232:233], v[232:233], v[234:235]
  s_waitcnt lgkmcnt(0)
  v_pk_add_f32 v[236:237], v[236:237], v[238:239]
  v_add_f32 v232, v232, v233
  v_add_f32 v236, v236, v237
  v_cvt_pk_bf16_f32 v4, v232, v236
  s_cmp_eq_u32 s43, 0
  s_cbranch_scc1 Lsts_43
  global_store_dwordx2 v252, v[4:5], s[26:27]
  s_branch Lste_44
Lsts_43:
  global_store_dwordx2 v252, v[4:5], s[26:27] sc1
Lste_44:
  global_load_dwordx4 v[136:139], v254, s[26:27] sc1
  global_load_dwordx4 v[140:143], v254, s[26:27] offset:512 sc1
  s_waitcnt vmcnt(9)
  v_xor_b32 v10, s31, v33
  v_xor_b32 v11, s31, v35
  v_xor_b32 v238, s31, v37
  v_or3_b32 v10, v10, v11, v238
  v_xor_b32 v11, s31, v39
  v_or_b32 v10, v10, v11
  v_cmp_ne_u32 vcc, 0, v10
  s_cbranch_vccz Lst_ok_46
  s_mov_b32 s37, 400000
Lst_retry_45:
  s_mov_b64 exec, vcc
  global_load_dwordx4 v[32:35], v253, s[26:27] sc1
  global_load_dwordx4 v[36:39], v253, s[26:27] offset:128 sc1
  s_waitcnt vmcnt(0)
  v_xor_b32 v10, s31, v33
  v_xor_b32 v11, s31, v35
  v_xor_b32 v238, s31, v37
  v_or3_b32 v10, v10, v11, v238
  v_xor_b32 v11, s31, v39
  v_or_b32 v10, v10, v11
  v_cmp_ne_u32 vcc, 0, v10
  s_cbranch_vccz Lst_ok_46_x
  s_sub_u32 s37, s37, 1
  s_cmp_lg_u32 s37, 0
  s_cbranch_scc1 Lst_retry_45
Lst_ok_46_x:
  s_mov_b64 exec, -1
Lst_ok_46:
  v_max_f32 v6, v32, v36
  s_nop 1
  v_max_f32_dpp v6, v6, v6 quad_perm:[1,0,3,2] row_mask:0xf bank_mask:0xf
  s_nop 1
  v_max_f32_dpp v6, v6, v6 quad_perm:[2,3,0,1] row_mask:0xf bank_mask:0xf
  s_nop 1
  v_max_f32_dpp v6, v6, v6 row_half_mirror row_mask:0xf bank_mask:0xf
  v_sub_f32 v7, v32, v6
  v_sub_f32 v8, v36, v6
  v_exp_f32 v7, v7
  v_exp_f32 v8, v8
  s_nop 0
  v_mul_f32 v6, v7, v34
  v_fma_f32 v6, v8, v38, v6
  s_nop 1
  v_add_f32_dpp v6, v6, v6 quad_perm:[1,0,3,2] row_mask:0xf bank_mask:0xf
  s_nop 1
  v_add_f32_dpp v6, v6, v6 quad_perm:[2,3,0,1] row_mask:0xf bank_mask:0xf
  s_nop 1
  v_add_f32_dpp v6, v6, v6 row_half_mirror row_mask:0xf bank_mask:0xf
  v_rcp_f32 v6, v6
  s_nop 0
  v_mul_f32 v7, v7, v6
  v_mul_f32 v8, v8, v6
  s_cmp_ge_u32 s2, 224
  s_cbranch_scc1 LskipB_47
  s_waitcnt vmcnt(7)
  v_mfma_f32_16x16x32_bf16 v[28:31], v[220:223], v[208:211], v[28:31]
  v_mfma_f32_16x16x32_bf16 v[28:31], v[224:227], v[212:215], v[28:31]
LskipB_47:
  s_mov_b32 s37, 400000
  global_load_dwordx4 v[136:139], v254, s[26:27] sc1
  global_load_dwordx4 v[140:143], v254, s[26:27] offset:512 sc1
Lh1_loop_48:
  global_load_dwordx4 v[136:139], v254, s[26:27] sc1
  global_load_dwordx4 v[140:143], v254, s[26:27] offset:512 sc1
Lh1_first_50:
  s_waitcnt vmcnt(4)
  v_xor_b32 v10, s31, v137
  v_xor_b32 v11, s31, v139
  v_xor_b32 v238, s31, v141
  v_or3_b32 v10, v10, v11, v238
  v_xor_b32 v11, s31, v143
  v_or_b32 v10, v10, v11
  v_cmp_ne_u32 vcc, 0, v10
  s_cbranch_vccz Lh1_ok_49
  s_mov_b64 exec, vcc
  s_sub_u32 s37, s37, 1
  s_cmp_lg_u32 s37, 0
  s_cbranch_scc1 Lh1_loop_48
Lh1_ok_49:
  s_mov_b64 exec, -1
  v_lshlrev_b32 v232, 16, v136
  v_and_b32 v233, 0xffff0000, v136
  v_lshlrev_b32 v234, 16, v138
  v_and_b32 v235, 0xffff0000, v138
  v_lshlrev_b32 v236, 16, v140
  v_and_b32 v237, 0xffff0000, v140
  v_lshlrev_b32 v238, 16, v142
  v_and_b32 v239, 0xffff0000, v142
  v_mul_f32 v232, v232, v7
  v_mul_f32 v233, v233, v7
  v_mul_f32 v234, v234, v7
  v_mul_f32 v235, v235, v7
  v_fma_f32 v232, v236, v8, v232
  v_fma_f32 v233, v237, v8, v233
  v_fma_f32 v234, v238, v8, v234
  v_fma_f32 v235, v239, v8, v235
  v_add_f32_dpp v232, v232, v232 quad_perm:[1,0,3,2] row_mask:0xf bank_mask:0xf
  v_add_f32_dpp v233, v233, v233 quad_perm:[1,0,3,2] row_mask:0xf bank_mask:0xf
  v_add_f32_dpp v234, v234, v234 quad_perm:[1,0,3,2] row_mask:0xf bank_mask:0xf
  v_add_f32_dpp v235, v235, v235 quad_perm:[1,0,3,2] row_mask:0xf bank_mask:0xf
  v_add_f32_dpp v232, v232, v232 quad_perm:[2,3,0,1] row_mask:0xf bank_mask:0xf
  v_add_f32_dpp v233, v233, v233 quad_perm:[2,3,0,1] row_mask:0xf bank_mask:0xf
  v_add_f32_dpp v234, v234, v234 quad_perm:[2,3,0,1] row_mask:0xf bank_mask:0xf
  v_add_f32_dpp v235, v235, v235 quad_perm:[2,3,0,1] row_mask:0xf bank_mask:0xf
  v_add_f32_dpp v232, v232, v232 row_half_mirror row_mask:0xf bank_mask:0xf
  v_add_f32_dpp v233, v233, v233 row_half_mirror row_mask:0xf bank_mask:0xf
  v_add_f32_dpp v234, v234, v234 row_half_mirror row_mask:0xf bank_mask:0xf
  v_add_f32_dpp v235, v235, v235 row_half_mirror row_mask:0xf bank_mask:0xf
  v_cvt_pk_bf16_f32 v232, v232, v232
  v_cvt_pk_bf16_f32 v233, v233, v233
  v_cvt_pk_bf16_f32 v234, v234, v234
  v_cvt_pk_bf16_f32 v235, v235, v235
  v_and_b32 v32, v232, v14
  v_and_b32 v33, v232, v15
  v_and_b32 v34, v232, v16
  v_and_b32 v35, v232, v17
  v_and_b32 v36, v233, v14
  v_and_b32 v37, v233, v15
  v_and_b32 v38, v233, v16
  v_and_b32 v39, v233, v17
  v_and_b32 v40, v234, v14
  v_and_b32 v41, v234, v15
  v_and_b32 v42, v234, v16
  v_and_b32 v43, v234, v17
  v_and_b32 v44, v235, v14
  v_and_b32 v45, v235, v15
  v_and_b32 v46, v235, v16
  v_and_b32 v47, v235, v17
  v_mov_b32 v237, s31
  v_mov_b32 v239, s31
  v_mfma_f32_16x16x32_bf16 v[28:31], v[32:35], v[192:195], v[28:31]
  v_mfma_f32_16x16x32_bf16 v[28:31], v[36:39], v[196:199], v[28:31]
  v_mfma_f32_16x16x32_bf16 v[28:31], v[40:43], v[200:203], v[28:31]
  v_mfma_f32_16x16x32_bf16 v[28:31], v[44:47], v[204:207], v[28:31]
  s_nop 7
  v_cvt_pk_bf16_f32 v236, v28, v29
  v_cvt_pk_bf16_f32 v238, v30, v31
  s_cmp_eq_u32 s43, 0
  s_cbranch_scc1 Lsts_51
  global_store_dwordx4 v255, v[236:239], s[26:27]
  s_branch Lste_52
Lsts_51:
  global_store_dwordx4 v255, v[236:239], s[26:27] sc1
Lste_52:
  global_load_dwordx4 v[64:67], v244, s[26:27] sc1
  v_mov_b32 v7, s31
  s_mov_b32 s37, 400000
  s_branch Lh2_first_55
Lh2_loop_53:
  global_load_dwordx4 v[64:67], v244, s[26:27] sc1
Lh2_first_55:
  s_waitcnt vmcnt(0)
  v_xor_b32 v10, s31, v65
  v_xor_b32 v11, s31, v67
  v_or_b32 v10, v10, v11
  v_cmp_ne_u32 vcc, 0, v10
  s_cbranch_vccz Lh2_ok_54
  s_mov_b64 exec, vcc
  s_sub_u32 s37, s37, 1
  s_cmp_lg_u32 s37, 0
  s_cbranch_scc1 Lh2_loop_53
Lh2_ok_54:
  s_mov_b64 exec, -1
  v_lshlrev_b32 v48, 16, v64
  v_and_b32 v49, 0xffff0000, v64
  v_lshlrev_b32 v50, 16, v66
  v_and_b32 v51, 0xffff0000, v66
  s_nop 1
  v_permlane32_swap_b32 v48, v50
  v_permlane32_swap_b32 v49, v51
  v_add_f32 v48, v48, v50
  v_add_f32 v49, v49, v51
  s_nop 1
  v_permlane16_swap_b32 v48, v49
  v_add_f32 v48, v48, v49
  s_nop 1
  v_add_f32_dpp v48, v48, v48 row_ror:8 row_mask:0xf bank_mask:0xf
  s_nop 1
  v_add_f32_dpp v48, v48, v48 row_ror:4 row_mask:0xf bank_mask:0xf
  s_nop 1
  v_add_f32_dpp v6, v48, v48 quad_perm:[2,3,0,1] row_mask:0xf bank_mask:0xf
  s_mov_b32 exec_lo, 0x00030003
  s_mov_b32 exec_hi, 0x00030003
  global_store_dwordx2 v231, v[6:7], s[26:27] sc1
  s_mov_b64 exec, -1
  s_and_b32 s33, s29, 7
  s_cmp_lg_u32 s33, s28
  s_cbranch_scc1 Lend
  s_cmp_lg_u32 s32, 0
  s_cbranch_scc1 Lend
  s_lshl_b32 s33, s29, 11
  s_add_u32 s33, s33, 3145728
  v_lshrrev_b32 v9, 3, v1
  v_lshlrev_b32 v9, 8, v9
  v_and_b32 v4, 7, v1
  v_lshl_add_u32 v9, v4, 4, v9
  v_add_u32 v9, s33, v9
  s_lshl_b32 s33, s29, 6
  v_lshlrev_b32 v8, 2, v4
  v_add_u32 v8, s33, v8
  global_load_dword v18, v8, s[4:5]
  global_load_dword v19, v8, s[4:5] offset:32
  s_mov_b32 s37, 400000
Lh3_loop_56:
  global_load_dwordx4 v[68:71], v9, s[26:27] sc1
  global_load_dwordx4 v[72:75], v9, s[26:27] offset:128 sc1
Lh3_first_58:
  s_waitcnt vmcnt(0)
  v_xor_b32 v10, s31, v69
  v_xor_b32 v11, s31, v71
  v_xor_b32 v238, s31, v73
  v_or3_b32 v10, v10, v11, v238
  v_xor_b32 v11, s31, v75
  v_or_b32 v10, v10, v11
  v_cmp_ne_u32 vcc, 0, v10
  s_cbranch_vccz Lh3_ok_57
  s_mov_b64 exec, vcc
  s_sub_u32 s37, s37, 1
  s_cmp_lg_u32 s37, 0
  s_cbranch_scc1 Lh3_loop_56
Lh3_ok_57:
  s_mov_b64 exec, -1
  v_add_f32_dpp v48, v68, v68 row_ror:8 row_mask:0xf bank_mask:0xf
  v_add_f32_dpp v49, v70, v70 row_ror:8 row_mask:0xf bank_mask:0xf
  v_add_f32_dpp v50, v72, v72 row_ror:8 row_mask:0xf bank_mask:0xf
  v_add_f32_dpp v51, v74, v74 row_ror:8 row_mask:0xf bank_mask:0xf
  v_mov_b32 v52, v48
  v_mov_b32 v53, v49
  v_mov_b32 v54, v50
  v_mov_b32 v55, v51
  s_nop 1
  v_permlane16_swap_b32 v48, v52
  v_permlane16_swap_b32 v49, v53
  v_permlane16_swap_b32 v50, v54
  v_permlane16_swap_b32 v51, v55
  v_add_f32 v48, v48, v52
  v_add_f32 v49, v49, v53
  v_add_f32 v50, v50, v54
  v_add_f32 v51, v51, v55
  v_mov_b32 v52, v48
  v_mov_b32 v53, v49
  v_mov_b32 v54, v50
  v_mov_b32 v55, v51
  s_nop 0
  v_permlane32_swap_b32 v48, v52
  v_permlane32_swap_b32 v49, v53
  v_permlane32_swap_b32 v50, v54
  v_permlane32_swap_b32 v51, v55
  v_add_f32 v48, v48, v52
  v_add_f32 v49, v49, v53
  v_add_f32 v50, v50, v54
  v_add_f32 v51, v51, v55
  v_lshlrev_b32 v56, 16, v18
  v_and_b32 v57, 0xffff0000, v18
  v_lshlrev_b32 v58, 16, v19
  v_and_b32 v59, 0xffff0000, v19
  v_pk_add_f32 v[48:49], v[48:49], v[56:57]
  v_pk_add_f32 v[50:51], v[50:51], v[58:59]
  v_cvt_pk_bf16_f32 v48, v48, v49
  v_cvt_pk_bf16_f32 v50, v50, v51
  s_mov_b64 exec, 0xff
  global_store_dword v8, v48, s[22:23]
  global_store_dword v8, v50, s[22:23] offset:32
  s_cmp_lg_u32 s29, 0
  s_cbranch_scc1 Lend
  v_mov_b32 v8, 0
  v_mov_b32 v9, s31
  s_mov_b64 exec, 1
  global_store_dword v8, v9, s[26:27] sc1
  s_branch Lend
Laux:
  s_setprio 3
  s_sub_u32 s62, s32, 4
  s_cmp_eq_u32 s62, 0
  s_cselect_b32 s33, 0, s2
  s_cmp_ge_u32 s33, 224
  s_cbranch_scc1 Lend
  v_lshlrev_b32 v5, 4, v1
  v_lshrrev_b32 v6, 3, v1
  v_and_b32 v7, 7, v1
  s_and_b32 s57, s29, 3
  s_lshr_b32 s33, s29, 2
  s_lshl_b32 s34, s28, 3
  s_add_u32 s33, s33, s34
  s_lshl_b32 s33, s33, 7
  s_lshl_b32 s34, s57, 20
  s_add_u32 s35, s33, s34
  s_movk_i32 s56, 0x2000
  s_cmp_eq_u32 s62, 0
  s_cbranch_scc1 Laux_w
  s_and_b32 s57, s2, 3
  s_lshr_b32 s33, s2, 2
  s_cmp_ge_u32 s33, 28
  s_cselect_b32 s36, 1, 0
  s_cselect_b32 s34, 28, 0
  s_sub_u32 s33, s33, s34
  s_lshl_b32 s35, s33, 7
  s_mul_i32 s34, s57, 458752
  s_add_u32 s35, s35, s34
  s_movk_i32 s56, 3584
  s_mov_b32 s58, s33
  s_mov_b32 s59, s36
  s_waitcnt lgkmcnt(0)
  s_cmp_eq_u32 s36, 0
  s_cselect_b32 s10, s16, s18
  s_cselect_b32 s11, s17, s19
Laux_w:
  v_mul_lo_u32 v6, v6, s56
  v_lshl_add_u32 v6, v7, 4, v6
  s_lshl_b32 s33, s57, 8
  v_lshlrev_b32 v4, 2, v1
  v_add_u32 v4, s33, v4
  s_lshl_b32 s33, s56, 3
  s_waitcnt lgkmcnt(0)
  s_add_u32 s52, s10, s35
  s_addc_u32 s53, s11, 0
  global_load_dwordx4 v[232:235], v5, s[4:5]
  global_load_dwordx4 v[236:239], v5, s[4:5] offset:1024
  global_load_dword v18, v11, s[26:27] sc1
  global_load_dword v32, v4, s[4:5]
  global_load_dword v33, v4, s[4:5] offset:1024
  global_load_dwordx4 v[64:67], v6, s[52:53] nt
  v_add_u32 v6, s33, v6
  global_load_dwordx4 v[68:71], v6, s[52:53] nt
  v_add_u32 v6, s33, v6
  global_load_dwordx4 v[72:75], v6, s[52:53] nt
  v_add_u32 v6, s33, v6
  global_load_dwordx4 v[76:79], v6, s[52:53] nt
  v_add_u32 v6, s33, v6
  global_load_dwordx4 v[80:83], v6, s[52:53] nt
  v_add_u32 v6, s33, v6
  global_load_dwordx4 v[84:87], v6, s[52:53] nt
  v_add_u32 v6, s33, v6
  global_load_dwordx4 v[88:91], v6, s[52:53] nt
  v_add_u32 v6, s33, v6
  global_load_dwordx4 v[92:95], v6, s[52:53] nt
  v_add_u32 v6, s33, v6
  global_load_dwordx4 v[96:99], v6, s[52:53] nt
  v_add_u32 v6, s33, v6
  global_load_dwordx4 v[100:103], v6, s[52:53] nt
  v_add_u32 v6, s33, v6
  global_load_dwordx4 v[104:107], v6, s[52:53] nt
  v_add_u32 v6, s33, v6
  global_load_dwordx4 v[108:111], v6, s[52:53] nt
  v_add_u32 v6, s33, v6
  global_load_dwordx4 v[112:115], v6, s[52:53] nt
  v_add_u32 v6, s33, v6
  global_load_dwordx4 v[116:119], v6, s[52:53] nt
  v_add_u32 v6, s33, v6
  global_load_dwordx4 v[120:123], v6, s[52:53] nt
  v_add_u32 v6, s33, v6
  global_load_dwordx4 v[124:127], v6, s[52:53] nt
  s_barrier
  v_mov_b32 v128, 0
  v_mov_b32 v129, 0
  v_mov_b32 v132, 0
  v_mov_b32 v133, 0
  v_mov_b32 v136, 0
  v_mov_b32 v137, 0
  v_mov_b32 v140, 0
  v_mov_b32 v141, 0
  v_mov_b32 v144, 0
  v_mov_b32 v145, 0
  v_mov_b32 v148, 0
  v_mov_b32 v149, 0
  v_mov_b32 v152, 0
  v_mov_b32 v153, 0
  v_mov_b32 v156, 0
  v_mov_b32 v157, 0
  v_mov_b32 v160, 0
  v_mov_b32 v161, 0
  v_mov_b32 v164, 0
  v_mov_b32 v165, 0
  v_mov_b32 v168, 0
  v_mov_b32 v169, 0
  v_mov_b32 v172, 0
  v_mov_b32 v173, 0
  v_mov_b32 v176, 0
  v_mov_b32 v177, 0
  v_mov_b32 v180, 0
  v_mov_b32 v181, 0
  v_mov_b32 v184, 0
  v_mov_b32 v185, 0
  v_mov_b32 v188, 0
  v_mov_b32 v189, 0
  v_mov_b32 v192, 0
  v_mov_b32 v193, 0
  s_mov_b32 s33, 0xffff
  s_mov_b32 s34, 0xffff0000
  v_and_b32 v8, 1, v1
  v_cmp_eq_u32 vcc, 1, v8
  v_mov_b32 v9, s33
  v_mov_b32 v10, s34
  v_cndmask_b32 v9, v9, v10, vcc
  v_and_b32 v8, 2, v1
  v_cmp_eq_u32 vcc, 0, v8
  s_nop 1
  v_cndmask_b32 v12, 0, v9, vcc
  v_cmp_ne_u32 vcc, 0, v8
  s_nop 1
  v_cndmask_b32 v13, 0, v9, vcc
  s_lshl_b32 s33, s62, 10
  v_and_b32 v240, 3, v1
  v_lshlrev_b32 v240, 7, v240
  v_lshrrev_b32 v8, 2, v1
  v_lshl_add_u32 v240, v8, 2, v240
  v_add_u32 v240, s33, v240
  v_bfe_u32 v241, v1, 2, 1
  v_lshlrev_b32 v241, 9, v241
  v_lshl_add_u32 v241, v3, 7, v241
  v_bfe_u32 v8, v1, 3, 1
  v_lshl_add_u32 v241, v8, 6, v241
  v_add_u32 v241, s33, v241
  v_lshlrev_b32 v242, 8, v3
  v_and_b32 v8, 7, v1
  v_lshl_add_u32 v242, v8, 5, v242
  v_add_u32 v242, s33, v242
  s_cmp_eq_u32 s62, 0
  s_cbranch_scc0 Laux_g1
  v_and_b32 v9, 31, v1
  v_lshrrev_b32 v10, 5, v1
  v_lshlrev_b32 v243, 3, v9
  v_lshl_add_u32 v243, v10, 8, v243
  s_lshl_b32 s34, s28, 15
  s_lshl_b32 s35, s57, 12
  s_add_u32 s34, s34, s35
  s_lshr_b32 s35, s29, 2
  s_lshl_b32 s35, s35, 9
  s_add_u32 s34, s34, s35
  s_add_u32 s34, s34, 262144
  v_lshlrev_b32 v10, 14, v10
  v_lshl_add_u32 v9, v9, 4, v10
  v_add_u32 v244, s34, v9
  s_branch Laux_g2
Laux_g1:
  v_lshrrev_b32 v9, 3, v1
  v_and_b32 v10, 3, v1
  v_lshl_add_u32 v243, v9, 2, v10
  v_lshlrev_b32 v243, 3, v243
  v_bfe_u32 v10, v1, 2, 1
  v_lshl_add_u32 v243, v10, 8, v243
  v_add_u32 v243, 1024, v243
  s_lshl_b32 s34, s58, 13
  s_lshl_b32 s35, s59, 2
  s_add_u32 s35, s35, s57
  s_lshl_b32 s35, s35, 7
  s_add_u32 s34, s34, s35
  s_add_u32 s34, s34, 524288
  v_lshlrev_b32 v9, 10, v9
  v_and_b32 v10, 7, v1
  v_lshl_add_u32 v9, v10, 4, v9
  v_add_u32 v244, s34, v9
Laux_g2:
  s_waitcnt vmcnt(16)
  v_readfirstlane_b32 s31, v18
  v_lshlrev_b32 v216, 16, v232
  v_lshlrev_b32 v217, 16, v236
  v_and_b32 v218, 0xffff0000, v232
  v_and_b32 v219, 0xffff0000, v236
  v_lshlrev_b32 v220, 16, v233
  v_lshlrev_b32 v221, 16, v237
  v_and_b32 v222, 0xffff0000, v233
  v_and_b32 v223, 0xffff0000, v237
  v_lshlrev_b32 v224, 16, v234
  v_lshlrev_b32 v225, 16, v238
  v_and_b32 v226, 0xffff0000, v234
  v_and_b32 v227, 0xffff0000, v238
  v_lshlrev_b32 v228, 16, v235
  v_lshlrev_b32 v229, 16, v239
  v_and_b32 v230, 0xffff0000, v235
  v_and_b32 v231, 0xffff0000, v239
  s_add_u32 s31, s31, 0x9e3779b9
  v_pk_add_f32 v[4:5], v[216:217], v[218:219]
  v_pk_add_f32 v[6:7], v[220:221], v[222:223]
  v_pk_add_f32 v[8:9], v[224:225], v[226:227]
  v_pk_add_f32 v[232:233], v[228:229], v[230:231]
  v_pk_add_f32 v[4:5], v[4:5], v[6:7]
  v_pk_add_f32 v[8:9], v[8:9], v[232:233]
  v_pk_add_f32 v[4:5], v[4:5], v[8:9]
  s_nop 0
  s_nop 0
  v_add_f32_dpp v4, v4, v4 row_ror:8 row_mask:0xf bank_mask:0xf
  v_add_f32_dpp v5, v5, v5 row_ror:8 row_mask:0xf bank_mask:0xf
  s_nop 0
  v_add_f32_dpp v4, v4, v4 row_ror:4 row_mask:0xf bank_mask:0xf
  v_add_f32_dpp v5, v5, v5 row_ror:4 row_mask:0xf bank_mask:0xf
  s_nop 0
  v_add_f32_dpp v4, v4, v4 row_ror:2 row_mask:0xf bank_mask:0xf
  v_add_f32_dpp v5, v5, v5 row_ror:2 row_mask:0xf bank_mask:0xf
  s_nop 0
  v_add_f32_dpp v4, v4, v4 row_ror:1 row_mask:0xf bank_mask:0xf
  v_add_f32_dpp v5, v5, v5 row_ror:1 row_mask:0xf bank_mask:0xf
  v_mov_b32 v6, v4
  v_mov_b32 v7, v5
  s_nop 0
  v_permlane16_swap_b32 v4, v6
  v_permlane16_swap_b32 v5, v7
  v_add_f32 v4, v4, v6
  v_add_f32 v5, v5, v7
  v_mov_b32 v6, v4
  v_mov_b32 v7, v5
  s_nop 0
  v_permlane32_swap_b32 v4, v6
  v_permlane32_swap_b32 v5, v7
  v_add_f32 v4, v4, v6
  v_add_f32 v5, v5, v7
  v_mul_f32 v4, 0x3b000000, v4
  v_mul_f32 v5, 0x3b000000, v5
  v_pk_add_f32 v[216:217], v[216:217], v[4:5] neg_lo:[0,1] neg_hi:[0,1]
  v_pk_add_f32 v[218:219], v[218:219], v[4:5] neg_lo:[0,1] neg_hi:[0,1]
  v_pk_add_f32 v[220:221], v[220:221], v[4:5] neg_lo:[0,1] neg_hi:[0,1]
  v_pk_add_f32 v[222:223], v[222:223], v[4:5] neg_lo:[0,1] neg_hi:[0,1]
  v_pk_add_f32 v[224:225], v[224:225], v[4:5] neg_lo:[0,1] neg_hi:[0,1]
  v_pk_add_f32 v[226:227], v[226:227], v[4:5] neg_lo:[0,1] neg_hi:[0,1]
  v_pk_add_f32 v[228:229], v[228:229], v[4:5] neg_lo:[0,1] neg_hi:[0,1]
  v_pk_add_f32 v[230:231], v[230:231], v[4:5] neg_lo:[0,1] neg_hi:[0,1]
  v_pk_mul_f32 v[6:7], v[216:217], v[216:217]
  v_pk_mul_f32 v[8:9], v[218:219], v[218:219]
  v_pk_fma_f32 v[6:7], v[220:221], v[220:221], v[6:7]
  v_pk_fma_f32 v[8:9], v[222:223], v[222:223], v[8:9]
  v_pk_fma_f32 v[6:7], v[224:225], v[224:225], v[6:7]
  v_pk_fma_f32 v[8:9], v[226:227], v[226:227], v[8:9]
  v_pk_fma_f32 v[6:7], v[228:229], v[228:229], v[6:7]
  v_pk_fma_f32 v[8:9], v[230:231], v[230:231], v[8:9]
  v_pk_add_f32 v[6:7], v[6:7], v[8:9]
  v_lshlrev_b32 v216, 16, v32
  v_lshlrev_b32 v217, 16, v33
  v_and_b32 v218, 0xffff0000, v32
  v_and_b32 v219, 0xffff0000, v33
  s_nop 0
  v_add_f32_dpp v6, v6, v6 row_ror:8 row_mask:0xf bank_mask:0xf
  v_add_f32_dpp v7, v7, v7 row_ror:8 row_mask:0xf bank_mask:0xf
  s_nop 0
  v_add_f32_dpp v6, v6, v6 row_ror:4 row_mask:0xf bank_mask:0xf
  v_add_f32_dpp v7, v7, v7 row_ror:4 row_mask:0xf bank_mask:0xf
  s_nop 0
  v_add_f32_dpp v6, v6, v6 row_ror:2 row_mask:0xf bank_mask:0xf
  v_add_f32_dpp v7, v7, v7 row_ror:2 row_mask:0xf bank_mask:0xf
  s_nop 0
  v_add_f32_dpp v6, v6, v6 row_ror:1 row_mask:0xf bank_mask:0xf
  v_add_f32_dpp v7, v7, v7 row_ror:1 row_mask:0xf bank_mask:0xf
  v_mov_b32 v8, v6
  v_mov_b32 v9, v7
  s_nop 0
  v_permlane16_swap_b32 v6, v8
  v_permlane16_swap_b32 v7, v9
  v_add_f32 v6, v6, v8
  v_add_f32 v7, v7, v9
  v_mov_b32 v8, v6
  v_mov_b32 v9, v7
  s_nop 0
  v_permlane32_swap_b32 v6, v8
  v_permlane32_swap_b32 v7, v9
  v_add_f32 v6, v6, v8
  v_add_f32 v7, v7, v9
  v_mul_f32 v6, 0x3b000000, v6
  v_mul_f32 v7, 0x3b000000, v7
  v_cvt_pk_bf16_f32 v10, v4, v5
  v_lshlrev_b32 v4, 16, v10
  v_and_b32 v5, 0xffff0000, v10
  v_cvt_pk_bf16_f32 v10, v6, v7
  v_lshlrev_b32 v6, 16, v10
  v_and_b32 v7, 0xffff0000, v10
  v_add_f32 v6, 0x3727c5ac, v6
  v_add_f32 v7, 0x3727c5ac, v7
  v_pk_add_f32 v[216:217], v[216:217], v[4:5] neg_lo:[0,1] neg_hi:[0,1]
  v_pk_add_f32 v[218:219], v[218:219], v[4:5] neg_lo:[0,1] neg_hi:[0,1]
  v_cvt_pk_bf16_f32 v10, v6, v7
  v_lshlrev_b32 v6, 16, v10
  v_and_b32 v7, 0xffff0000, v10
  v_sqrt_f32 v6, v6
  v_sqrt_f32 v7, v7
  v_cvt_pk_bf16_f32 v10, v216, v217
  v_lshlrev_b32 v216, 16, v10
  v_and_b32 v217, 0xffff0000, v10
  v_cvt_pk_bf16_f32 v10, v218, v219
  v_lshlrev_b32 v218, 16, v10
  v_and_b32 v219, 0xffff0000, v10
  v_cvt_pk_bf16_f32 v10, v6, v7
  v_lshlrev_b32 v6, 16, v10
  v_and_b32 v7, 0xffff0000, v10
  v_rcp_f32 v6, v6
  v_rcp_f32 v7, v7
  s_nop 0
  v_pk_mul_f32 v[216:217], v[216:217], v[6:7]
  v_pk_mul_f32 v[218:219], v[218:219], v[6:7]
  v_cvt_pk_bf16_f32 v216, v216, v216
  v_cvt_pk_bf16_f32 v217, v217, v217
  v_cvt_pk_bf16_f32 v218, v218, v218
  v_cvt_pk_bf16_f32 v219, v219, v219
  ds_write_b32 v240, v216 offset:0
  ds_write_b32 v240, v217 offset:512
  ds_write_b32 v240, v218 offset:64
  ds_write_b32 v240, v219 offset:576
  ds_read_b128 v[48:51], v241 offset:0
  ds_read_b128 v[52:55], v241 offset:16
  ds_read_b128 v[56:59], v241 offset:32
  ds_read_b128 v[60:63], v241 offset:48
  s_waitcnt lgkmcnt(3)
  v_and_b32 v130, v48, v12
  v_and_b32 v131, v48, v13
  v_and_b32 v134, v49, v12
  v_and_b32 v135, v49, v13
  v_and_b32 v138, v50, v12
  v_and_b32 v139, v50, v13
  v_and_b32 v142, v51, v12
  v_and_b32 v143, v51, v13
  s_waitcnt lgkmcnt(2)
  v_and_b32 v146, v52, v12
  v_and_b32 v147, v52, v13
  v_and_b32 v150, v53, v12
  v_and_b32 v151, v53, v13
  v_and_b32 v154, v54, v12
  v_and_b32 v155, v54, v13
  v_and_b32 v158, v55, v12
  v_and_b32 v159, v55, v13
  s_waitcnt lgkmcnt(1)
  v_and_b32 v162, v56, v12
  v_and_b32 v163, v56, v13
  v_and_b32 v166, v57, v12
  v_and_b32 v167, v57, v13
  v_and_b32 v170, v58, v12
  v_and_b32 v171, v58, v13
  v_and_b32 v174, v59, v12
  v_and_b32 v175, v59, v13
  s_waitcnt lgkmcnt(0)
  v_and_b32 v178, v60, v12
  v_and_b32 v179, v60, v13
  v_and_b32 v182, v61, v12
  v_and_b32 v183, v61, v13
  v_and_b32 v186, v62, v12
  v_and_b32 v187, v62, v13
  v_and_b32 v190, v63, v12
  v_and_b32 v191, v63, v13
  v_mov_b32 v233, s31
  v_mov_b32 v235, s31
  s_waitcnt vmcnt(15)
  v_mfma_f32_16x16x32_bf16 v[20:23], v[130:133], v[64:67], 0
  v_mfma_f32_16x16x32_bf16 v[24:27], v[128:131], v[64:67], 0
  s_waitcnt vmcnt(14)
  v_mfma_f32_16x16x32_bf16 v[20:23], v[134:137], v[68:71], v[20:23]
  v_mfma_f32_16x16x32_bf16 v[24:27], v[132:135], v[68:71], v[24:27]
  s_waitcnt vmcnt(13)
  v_mfma_f32_16x16x32_bf16 v[20:23], v[138:141], v[72:75], v[20:23]
  v_mfma_f32_16x16x32_bf16 v[24:27], v[136:139], v[72:75], v[24:27]
  s_waitcnt vmcnt(12)
  v_mfma_f32_16x16x32_bf16 v[20:23], v[142:145], v[76:79], v[20:23]
  v_mfma_f32_16x16x32_bf16 v[24:27], v[140:143], v[76:79], v[24:27]
  s_waitcnt vmcnt(11)
  v_mfma_f32_16x16x32_bf16 v[20:23], v[146:149], v[80:83], v[20:23]
  v_mfma_f32_16x16x32_bf16 v[24:27], v[144:147], v[80:83], v[24:27]
  s_waitcnt vmcnt(10)
  v_mfma_f32_16x16x32_bf16 v[20:23], v[150:153], v[84:87], v[20:23]
  v_mfma_f32_16x16x32_bf16 v[24:27], v[148:151], v[84:87], v[24:27]
  s_waitcnt vmcnt(9)
  v_mfma_f32_16x16x32_bf16 v[20:23], v[154:157], v[88:91], v[20:23]
  v_mfma_f32_16x16x32_bf16 v[24:27], v[152:155], v[88:91], v[24:27]
  s_waitcnt vmcnt(8)
  v_mfma_f32_16x16x32_bf16 v[20:23], v[158:161], v[92:95], v[20:23]
  v_mfma_f32_16x16x32_bf16 v[24:27], v[156:159], v[92:95], v[24:27]
  s_waitcnt vmcnt(7)
  v_mfma_f32_16x16x32_bf16 v[20:23], v[162:165], v[96:99], v[20:23]
  v_mfma_f32_16x16x32_bf16 v[24:27], v[160:163], v[96:99], v[24:27]
  s_waitcnt vmcnt(6)
  v_mfma_f32_16x16x32_bf16 v[20:23], v[166:169], v[100:103], v[20:23]
  v_mfma_f32_16x16x32_bf16 v[24:27], v[164:167], v[100:103], v[24:27]
  s_waitcnt vmcnt(5)
  v_mfma_f32_16x16x32_bf16 v[20:23], v[170:173], v[104:107], v[20:23]
  v_mfma_f32_16x16x32_bf16 v[24:27], v[168:171], v[104:107], v[24:27]
  s_waitcnt vmcnt(4)
  v_mfma_f32_16x16x32_bf16 v[20:23], v[174:177], v[108:111], v[20:23]
  v_mfma_f32_16x16x32_bf16 v[24:27], v[172:175], v[108:111], v[24:27]
  s_waitcnt vmcnt(3)
  v_mfma_f32_16x16x32_bf16 v[20:23], v[178:181], v[112:115], v[20:23]
  v_mfma_f32_16x16x32_bf16 v[24:27], v[176:179], v[112:115], v[24:27]
  s_waitcnt vmcnt(2)
  v_mfma_f32_16x16x32_bf16 v[20:23], v[182:185], v[116:119], v[20:23]
  v_mfma_f32_16x16x32_bf16 v[24:27], v[180:183], v[116:119], v[24:27]
  s_waitcnt vmcnt(1)
  v_mfma_f32_16x16x32_bf16 v[20:23], v[186:189], v[120:123], v[20:23]
  v_mfma_f32_16x16x32_bf16 v[24:27], v[184:187], v[120:123], v[24:27]
  s_waitcnt vmcnt(0)
  v_mfma_f32_16x16x32_bf16 v[20:23], v[190:193], v[124:127], v[20:23]
  v_mfma_f32_16x16x32_bf16 v[24:27], v[188:191], v[124:127], v[24:27]
  s_mov_b32 exec_lo, 0x00ff00ff
  s_mov_b32 exec_hi, 0xff00ff00
  s_nop 5
  ds_write_b128 v242, v[20:23] offset:2048
  ds_write_b128 v242, v[24:27] offset:2064
  s_mov_b64 exec, -1
  ds_read_b64 v[4:5], v243 offset:2048
  ds_read_b64 v[6:7], v243 offset:2560
  s_waitcnt lgkmcnt(0)
  v_add_f32 v232, v4, v6
  v_add_f32 v234, v5, v7
  global_store_dwordx4 v244, v[232:235], s[26:27] sc1
  s_cmp_lg_u32 s62, 0
  s_cbranch_scc1 Laux_h
  s_lshl_b32 s33, s28, 8
  s_lshl_b32 s34, s29, 3
  s_add_u32 s33, s33, s34
  s_add_u32 s33, s33, 32768
  v_mov_b32 v4, s33
  v_mov_b32 v6, s42
  v_mov_b32 v7, s31
  s_mov_b64 exec, 1
  global_store_dwordx2 v4, v[6:7], s[26:27] sc1
  s_branch Lend
Laux_h:
  s_lshl_b32 s33, s2, 10
  s_add_u32 s33, s33, 524288
  v_lshlrev_b32 v8, 4, v1
  v_add_u32 v245, s33, v8
  v_mov_b32 v230, 0
  v_mov_b32 v229, 1
  s_cmp_ge_u32 s63, 8
  s_cbranch_scc1 Lwpd_59
  s_mov_b32 s37, 400000
Lsp_60:
  ds_read_b32 v11, v230 offset:5440
  s_sub_u32 s37, s37, 1
  s_cbranch_scc1 Lspx_61
  s_waitcnt lgkmcnt(0)
  v_readfirstlane_b32 s63, v11
  s_cmp_lt_u32 s63, 8
  s_cbranch_scc1 Lsp_60
Lspx_61:
  s_waitcnt lgkmcnt(0)
Lwpd_59:
  global_load_dwordx4 v[232:235], v245, s[26:27] sc1
  s_waitcnt vmcnt(0)
  v_xor_b32 v10, s31, v233
  v_xor_b32 v11, s31, v235
  v_or_b32 v10, v10, v11
  v_cmp_ne_u32 vcc, 0, v10
  s_cbranch_vccz Lg_ok_63
  s_mov_b32 s37, 400000
Lg_retry_62:
  s_mov_b64 exec, vcc
  global_load_dwordx4 v[232:235], v245, s[26:27] sc1
  s_waitcnt vmcnt(0)
  v_xor_b32 v10, s31, v233
  v_xor_b32 v11, s31, v235
  v_or_b32 v10, v10, v11
  v_cmp_ne_u32 vcc, 0, v10
  s_cbranch_vccz Lg_ok_63_x
  s_sub_u32 s37, s37, 1
  s_cmp_lg_u32 s37, 0
  s_cbranch_scc1 Lg_retry_62
Lg_ok_63_x:
  s_mov_b64 exec, -1
Lg_ok_63:
  s_nop 1
  v_add_f32_dpp v232, v232, v232 row_ror:8 row_mask:0xf bank_mask:0xf
  v_mov_b32 v4, v232
  s_nop 1
  v_permlane16_swap_b32 v232, v4
  v_add_f32 v232, v232, v4
  s_nop 1
  v_add_f32_dpp v234, v234, v234 row_ror:8 row_mask:0xf bank_mask:0xf
  v_mov_b32 v4, v234
  s_nop 1
  v_permlane16_swap_b32 v234, v4
  v_add_f32 v234, v234, v4
  v_mov_b32 v233, v232
  s_nop 1
  v_permlane32_swap_b32 v232, v233
  v_mov_b32 v235, v234
  s_nop 1
  v_permlane32_swap_b32 v234, v235
  v_cvt_pk_bf16_f32 v10, v232, v234
  v_cvt_pk_bf16_f32 v11, v233, v235
  v_lshlrev_b32 v56, 16, v10
  v_and_b32 v57, 0xffff0000, v10
  v_lshlrev_b32 v58, 16, v11
  v_and_b32 v59, 0xffff0000, v11
  s_mov_b32 s38, 0xbfb8aa3b
  v_mul_f32 v56, s38, v56
  v_mul_f32 v57, s38, v57
  v_exp_f32 v56, v56
  v_exp_f32 v57, v57
  s_nop 0
  v_add_f32 v56, 1.0, v56
  v_add_f32 v57, 1.0, v57
  v_rcp_f32 v56, v56
  v_rcp_f32 v57, v57
  s_nop 0
  v_cvt_pk_bf16_f32 v10, v56, v57
  v_lshlrev_b32 v56, 16, v10
  v_and_b32 v57, 0xffff0000, v10
  v_pk_mul_f32 v[56:57], v[56:57], v[58:59]
  v_cvt_pk_bf16_f32 v60, v56, v56
  v_cvt_pk_bf16_f32 v61, v57, v57
  v_bfe_u32 v8, v1, 2, 1
  v_lshlrev_b32 v8, 6, v8
  v_and_b32 v9, 1, v1
  v_lshl_add_u32 v8, v9, 5, v8
  v_bfe_u32 v9, v1, 1, 1
  v_lshl_add_u32 v8, v9, 2, v8
  ds_write_b32 v8, v60 offset:5248
  ds_write_b32 v8, v61 offset:5264
  ds_write_b32 v230, v229 offset:5456
  s_branch Lend
Lload:
  s_setprio 3
  s_lshl_b32 s33, s30, 3
  s_add_u32 s33, s33, s28
  s_lshl_b32 s33, s33, 23
  s_and_b32 s34, s29, 15
  s_lshl_b32 s34, s34, 16
  s_add_u32 s33, s33, s34
  s_add_u32 s35, s33, 0x700000
  v_lshlrev_b32 v8, 2, v3
  v_xor_b32 v8, v8, v2
  v_lshlrev_b32 v9, 8, v3
  v_lshlrev_b32 v36, 4, v1
  v_lshlrev_b32 v4, 2, v1
  v_mov_b32 v5, 0
  ds_write_b32 v4, v5 offset:5504
  s_mov_b64 exec, 0xff
  ds_write_b32 v4, v5 offset:5440
  s_mov_b64 exec, -1
  v_xor_b32 v10, 0, v8
  v_lshl_add_u32 v32, v10, 4, v9
  v_xor_b32 v10, 1, v8
  v_lshl_add_u32 v33, v10, 4, v9
  v_xor_b32 v10, 2, v8
  v_lshl_add_u32 v34, v10, 4, v9
  v_xor_b32 v10, 3, v8
  v_lshl_add_u32 v35, v10, 4, v9
  s_mov_b32 s46, 0x10000
  s_mov_b32 s47, 0x20000
  s_mov_b32 s50, 0x10000
  s_mov_b32 s51, 0x20000
  s_waitcnt lgkmcnt(0)
  s_add_u32 s44, s6, s35
  s_addc_u32 s45, s7, 0
  s_and_b32 s45, s45, 0xffff
  s_add_u32 s48, s8, s35
  s_addc_u32 s49, s9, 0
  s_and_b32 s49, s49, 0xffff
  s_mul_i32 s57, s28, 0
  s_mul_i32 s36, s29, 1
  s_add_u32 s57, s57, s36
  s_mov_b32 s36, 0
  s_mov_b32 s58, 16384
  s_barrier
Lld_64:
  s_add_u32 s33, s36, s57
  s_and_b32 s33, s33, 15
  s_lshl_b32 s33, s33, 12
  s_sub_u32 s35, s36, 7
  s_max_i32 s35, s35, s63
  s_waitcnt vmcnt(28)
  s_mov_b32 s63, s35
  v_mov_b32 v5, s35
  ds_write_b32 v230, v5 offset:5440
  s_add_u32 m0, s58, 0
  s_add_u32 s34, s33, 0
  buffer_load_dwordx4 v32, s[44:47], s34 offen nt lds
  s_add_u32 m0, s58, 1024
  s_add_u32 s34, s33, 1024
  buffer_load_dwordx4 v33, s[44:47], s34 offen nt lds
  s_add_u32 m0, s58, 2048
  s_add_u32 s34, s33, 2048
  buffer_load_dwordx4 v34, s[44:47], s34 offen nt lds
  s_add_u32 m0, s58, 3072
  s_add_u32 s34, s33, 3072
  buffer_load_dwordx4 v35, s[44:47], s34 offen nt lds
  s_add_u32 s58, s58, 4096
  s_add_u32 s36, s36, 1
  s_cmp_lt_u32 s36, 16
  s_cbranch_scc1 Lld_64
Lld_65:
  s_add_u32 s33, s36, s57
  s_and_b32 s33, s33, 15
  s_lshl_b32 s33, s33, 12
  s_sub_u32 s35, s36, 10
  s_max_i32 s35, s35, s63
  s_waitcnt vmcnt(40)
  s_mov_b32 s63, s35
  v_mov_b32 v5, s35
  ds_write_b32 v230, v5 offset:5440
  s_add_u32 m0, s58, 0
  s_add_u32 s34, s33, 0
  buffer_load_dwordx4 v36, s[48:51], s34 offen nt lds
  s_add_u32 m0, s58, 1024
  s_add_u32 s34, s33, 1024
  buffer_load_dwordx4 v36, s[48:51], s34 offen nt lds
  s_add_u32 m0, s58, 2048
  s_add_u32 s34, s33, 2048
  buffer_load_dwordx4 v36, s[48:51], s34 offen nt lds
  s_add_u32 m0, s58, 3072
  s_add_u32 s34, s33, 3072
  buffer_load_dwordx4 v36, s[48:51], s34 offen nt lds
  s_add_u32 s58, s58, 4096
  s_add_u32 s36, s36, 1
  s_cmp_lt_u32 s36, 32
  s_cbranch_scc1 Lld_65
  s_waitcnt vmcnt(40)
  v_mov_b32 v5, 22
  ds_write_b32 v230, v5 offset:5440
  s_waitcnt vmcnt(36)
  v_mov_b32 v5, 23
  ds_write_b32 v230, v5 offset:5440
  s_waitcnt vmcnt(32)
  v_mov_b32 v5, 24
  ds_write_b32 v230, v5 offset:5440
  s_waitcnt vmcnt(28)
  v_mov_b32 v5, 25
  ds_write_b32 v230, v5 offset:5440
  s_waitcnt vmcnt(24)
  v_mov_b32 v5, 26
  ds_write_b32 v230, v5 offset:5440
  s_waitcnt vmcnt(20)
  v_mov_b32 v5, 27
  ds_write_b32 v230, v5 offset:5440
  s_waitcnt vmcnt(16)
  v_mov_b32 v5, 28
  ds_write_b32 v230, v5 offset:5440
  s_waitcnt vmcnt(12)
  v_mov_b32 v5, 29
  ds_write_b32 v230, v5 offset:5440
  s_waitcnt vmcnt(8)
  v_mov_b32 v5, 30
  ds_write_b32 v230, v5 offset:5440
  s_waitcnt vmcnt(4)
  v_mov_b32 v5, 31
  ds_write_b32 v230, v5 offset:5440
  s_waitcnt vmcnt(0)
  v_mov_b32 v5, 32
  ds_write_b32 v230, v5 offset:5440
Lend:
Lexit:
  s_endpgm
Lcode_end:
  .set CODE_CHUNKS, (Lcode_end-parallel_sum__sliding_block_cached__glu_gated_glu__decode_kernel)/1024

.section .rodata,"a"
.p2align 6
.amdhsa_kernel parallel_sum__sliding_block_cached__glu_gated_glu__decode_kernel
  .amdhsa_next_free_vgpr 256
  .amdhsa_next_free_sgpr 102
  .amdhsa_accum_offset 256
  .amdhsa_group_segment_fixed_size 0
  .amdhsa_kernarg_size 96
  .amdhsa_user_sgpr_count 2
  .amdhsa_user_sgpr_kernarg_segment_ptr 1
  .amdhsa_system_sgpr_workgroup_id_x 1
.end_amdhsa_kernel
```
